```python
import torch

def _softmax(x, axis=-1):
    return torch.softmax(x, dim=axis)
def _gelu(x):
    return torch.nn.functional.gelu(x, approximate="tanh")
def _silu(x):
    return torch.nn.functional.silu(x)
def _sigmoid(x):
    return torch.sigmoid(x)
def _layernorm(x, axis=-1, eps=1e-5):
    m = x.mean(dim=axis, keepdim=True)
    v = x.var(dim=axis, keepdim=True, unbiased=False)
    return (x - m) / torch.sqrt(v + eps)
def _scatter_add(tgt, idx, src, axis=0):
    return tgt.clone().index_add_(axis, idx, src)
def _segment_sum(src, seg, n):
    out = torch.zeros((n,) + src.shape[1:], dtype=src.dtype)
    return out.index_add_(0, seg, src)
def _pad(x, pw):
    flat = tuple(v for pair in reversed(pw) for v in pair)
    return torch.nn.functional.pad(x, flat)

kernel_name = 'standalone__rmsnorm__sampling'

def setup_inputs():

    _w = (lambda a: (lambda t: t.to(torch.bfloat16) if t.is_floating_point() else t)(torch.as_tensor(a)))
    B, S, D = 1024, 8, 640
    return {
        "x": _w((lambda *s: torch.randn(*s, dtype=torch.bfloat16) * 0.05)(B, S, D)),
        "g": _w((lambda *s: torch.randn(*s, dtype=torch.bfloat16) * 0.05)(D) + 1.0),
    }

def reference(x, g):
    rms = torch.sqrt((x * x).mean(axis=-1, keepdims=True) + 1e-6)
    return x / rms * g
```

```asm
; @launch grid=(256,1,1) block=(512,1,1) lds=1280
.amdgcn_target "amdgcn-amd-amdhsa--gfx950"
.text
.globl standalone__rmsnorm__sampling_kernel
.p2align 12
.p2align 8
.type standalone__rmsnorm__sampling_kernel,@function
standalone__rmsnorm__sampling_kernel:
    s_load_dwordx4 s[4:7], s[0:1], 0
    s_load_dwordx2 s[8:9], s[0:1], 16
    s_cmpk_ge_u32 s2, 256
    s_cbranch_scc1 L_done
    v_readfirstlane_b32 s11, v0
    s_and_b32 s12, s2, 7
    s_lshl_b32 s12, s12, 5
    s_lshr_b32 s13, s2, 3
    s_add_u32 s12, s12, s13
    s_mul_i32 s3, s12, 40960
    v_lshrrev_b32 v1, 4, v0
    v_and_b32 v2, 15, v0
    v_lshlrev_b32 v2, 4, v2
    v_mul_u32_u24 v1, 1280, v1
    v_add3_u32 v1, v1, v2, s3
    s_mov_b32 s10, 0xffff0000
    v_mov_b32 v3, 0
    s_cmp_lg_u32 s11, 0
    s_cbranch_scc1 L_nog
    v_lshlrev_b32 v84, 4, v0
    v_lshlrev_b32 v85, 2, v0
    s_mov_b32 m0, 0
    s_waitcnt lgkmcnt(0)
    global_load_lds_dwordx4 v84, s[6:7]
    global_load_lds_dword v85, s[6:7] offset:1024
L_nog:
    s_waitcnt lgkmcnt(0)
    global_load_dwordx4 v[4:7], v1, s[4:5] offset:0
    global_load_dwordx4 v[8:11], v1, s[4:5] offset:256
    global_load_dwordx4 v[12:15], v1, s[4:5] offset:512
    global_load_dwordx4 v[16:19], v1, s[4:5] offset:768
    global_load_dwordx4 v[20:23], v1, s[4:5] offset:1024
    s_waitcnt vmcnt(5)
    s_barrier
    ds_read_b128 v[24:27], v2 offset:0
    ds_read_b128 v[28:31], v2 offset:256
    ds_read_b128 v[32:35], v2 offset:512
    ds_read_b128 v[36:39], v2 offset:768
    ds_read_b128 v[40:43], v2 offset:1024
    s_cmpk_lt_u32 s11, 256
    s_waitcnt lgkmcnt(4)
    v_lshlrev_b32 v44, 16, v24
    v_and_b32 v45, s10, v24
    v_lshlrev_b32 v46, 16, v25
    v_and_b32 v47, s10, v25
    v_lshlrev_b32 v48, 16, v26
    v_and_b32 v49, s10, v26
    v_lshlrev_b32 v50, 16, v27
    v_and_b32 v51, s10, v27
    s_waitcnt lgkmcnt(3)
    v_lshlrev_b32 v52, 16, v28
    v_and_b32 v53, s10, v28
    v_lshlrev_b32 v54, 16, v29
    v_and_b32 v55, s10, v29
    v_lshlrev_b32 v56, 16, v30
    v_and_b32 v57, s10, v30
    v_lshlrev_b32 v58, 16, v31
    v_and_b32 v59, s10, v31
    s_waitcnt lgkmcnt(2)
    v_lshlrev_b32 v60, 16, v32
    v_and_b32 v61, s10, v32
    v_lshlrev_b32 v62, 16, v33
    v_and_b32 v63, s10, v33
    v_lshlrev_b32 v64, 16, v34
    v_and_b32 v65, s10, v34
    v_lshlrev_b32 v66, 16, v35
    v_and_b32 v67, s10, v35
    s_waitcnt lgkmcnt(1)
    v_lshlrev_b32 v68, 16, v36
    v_and_b32 v69, s10, v36
    v_lshlrev_b32 v70, 16, v37
    v_and_b32 v71, s10, v37
    v_lshlrev_b32 v72, 16, v38
    v_and_b32 v73, s10, v38
    v_lshlrev_b32 v74, 16, v39
    v_and_b32 v75, s10, v39
    s_waitcnt lgkmcnt(0)
    v_lshlrev_b32 v76, 16, v40
    v_and_b32 v77, s10, v40
    v_lshlrev_b32 v78, 16, v41
    v_and_b32 v79, s10, v41
    v_lshlrev_b32 v80, 16, v42
    v_and_b32 v81, s10, v42
    v_lshlrev_b32 v82, 16, v43
    v_and_b32 v83, s10, v43
    s_waitcnt vmcnt(4)
    v_dot2c_f32_bf16 v3, v4, v4
    v_dot2c_f32_bf16 v3, v5, v5
    v_dot2c_f32_bf16 v3, v6, v6
    v_dot2c_f32_bf16 v3, v7, v7
    v_lshlrev_b32 v24, 16, v4
    v_and_b32 v25, s10, v4
    v_pk_mul_f32 v[44:45], v[44:45], v[24:25]
    v_lshlrev_b32 v26, 16, v5
    v_and_b32 v27, s10, v5
    v_pk_mul_f32 v[46:47], v[46:47], v[26:27]
    v_lshlrev_b32 v28, 16, v6
    v_and_b32 v29, s10, v6
    v_pk_mul_f32 v[48:49], v[48:49], v[28:29]
    v_lshlrev_b32 v30, 16, v7
    v_and_b32 v31, s10, v7
    v_pk_mul_f32 v[50:51], v[50:51], v[30:31]
    s_waitcnt vmcnt(3)
    v_dot2c_f32_bf16 v3, v8, v8
    v_dot2c_f32_bf16 v3, v9, v9
    v_dot2c_f32_bf16 v3, v10, v10
    v_dot2c_f32_bf16 v3, v11, v11
    v_lshlrev_b32 v24, 16, v8
    v_and_b32 v25, s10, v8
    v_pk_mul_f32 v[52:53], v[52:53], v[24:25]
    v_lshlrev_b32 v26, 16, v9
    v_and_b32 v27, s10, v9
    v_pk_mul_f32 v[54:55], v[54:55], v[26:27]
    v_lshlrev_b32 v28, 16, v10
    v_and_b32 v29, s10, v10
    v_pk_mul_f32 v[56:57], v[56:57], v[28:29]
    v_lshlrev_b32 v30, 16, v11
    v_and_b32 v31, s10, v11
    v_pk_mul_f32 v[58:59], v[58:59], v[30:31]
    s_waitcnt vmcnt(2)
    v_dot2c_f32_bf16 v3, v12, v12
    v_dot2c_f32_bf16 v3, v13, v13
    v_dot2c_f32_bf16 v3, v14, v14
    v_dot2c_f32_bf16 v3, v15, v15
    v_lshlrev_b32 v24, 16, v12
    v_and_b32 v25, s10, v12
    v_pk_mul_f32 v[60:61], v[60:61], v[24:25]
    v_lshlrev_b32 v26, 16, v13
    v_and_b32 v27, s10, v13
    v_pk_mul_f32 v[62:63], v[62:63], v[26:27]
    v_lshlrev_b32 v28, 16, v14
    v_and_b32 v29, s10, v14
    v_pk_mul_f32 v[64:65], v[64:65], v[28:29]
    v_lshlrev_b32 v30, 16, v15
    v_and_b32 v31, s10, v15
    v_pk_mul_f32 v[66:67], v[66:67], v[30:31]
    s_waitcnt vmcnt(1)
    v_dot2c_f32_bf16 v3, v16, v16
    v_dot2c_f32_bf16 v3, v17, v17
    v_dot2c_f32_bf16 v3, v18, v18
    v_dot2c_f32_bf16 v3, v19, v19
    v_lshlrev_b32 v24, 16, v16
    v_and_b32 v25, s10, v16
    v_pk_mul_f32 v[68:69], v[68:69], v[24:25]
    v_lshlrev_b32 v26, 16, v17
    v_and_b32 v27, s10, v17
    v_pk_mul_f32 v[70:71], v[70:71], v[26:27]
    v_lshlrev_b32 v28, 16, v18
    v_and_b32 v29, s10, v18
    v_pk_mul_f32 v[72:73], v[72:73], v[28:29]
    v_lshlrev_b32 v30, 16, v19
    v_and_b32 v31, s10, v19
    v_pk_mul_f32 v[74:75], v[74:75], v[30:31]
    s_waitcnt vmcnt(0)
    s_cbranch_scc1 L_e1
    s_barrier
L_e1:
    v_dot2c_f32_bf16 v3, v20, v20
    v_dot2c_f32_bf16 v3, v21, v21
    v_dot2c_f32_bf16 v3, v22, v22
    v_dot2c_f32_bf16 v3, v23, v23
    v_lshlrev_b32 v24, 16, v20
    v_and_b32 v25, s10, v20
    v_pk_mul_f32 v[76:77], v[76:77], v[24:25]
    v_add_f32_dpp v3, v3, v3 row_ror:8 row_mask:0xf bank_mask:0xf
    v_lshlrev_b32 v26, 16, v21
    v_and_b32 v27, s10, v21
    v_add_f32_dpp v3, v3, v3 row_ror:4 row_mask:0xf bank_mask:0xf
    v_pk_mul_f32 v[78:79], v[78:79], v[26:27]
    v_lshlrev_b32 v28, 16, v22
    v_add_f32_dpp v3, v3, v3 row_ror:2 row_mask:0xf bank_mask:0xf
    v_and_b32 v29, s10, v22
    v_pk_mul_f32 v[80:81], v[80:81], v[28:29]
    v_add_f32_dpp v3, v3, v3 row_ror:1 row_mask:0xf bank_mask:0xf
    v_mov_b32 v2, 0x358637bd
    v_fmac_f32 v2, 0x3acccccd, v3
    v_rsq_f32 v2, v2
    v_lshlrev_b32 v30, 16, v23
    v_and_b32 v31, s10, v23
    v_pk_mul_f32 v[82:83], v[82:83], v[30:31]
    v_pk_mul_f32 v[44:45], v[44:45], v[2:3] op_sel_hi:[1,0]
    v_pk_mul_f32 v[46:47], v[46:47], v[2:3] op_sel_hi:[1,0]
    v_pk_mul_f32 v[48:49], v[48:49], v[2:3] op_sel_hi:[1,0]
    v_pk_mul_f32 v[50:51], v[50:51], v[2:3] op_sel_hi:[1,0]
    v_cvt_pk_bf16_f32 v4, v44, v45
    v_cvt_pk_bf16_f32 v5, v46, v47
    v_cvt_pk_bf16_f32 v6, v48, v49
    v_cvt_pk_bf16_f32 v7, v50, v51
    global_store_dwordx4 v1, v[4:7], s[8:9] offset:0 nt
    v_pk_mul_f32 v[52:53], v[52:53], v[2:3] op_sel_hi:[1,0]
    v_pk_mul_f32 v[54:55], v[54:55], v[2:3] op_sel_hi:[1,0]
    v_pk_mul_f32 v[56:57], v[56:57], v[2:3] op_sel_hi:[1,0]
    v_pk_mul_f32 v[58:59], v[58:59], v[2:3] op_sel_hi:[1,0]
    v_cvt_pk_bf16_f32 v8, v52, v53
    v_cvt_pk_bf16_f32 v9, v54, v55
    v_cvt_pk_bf16_f32 v10, v56, v57
    v_cvt_pk_bf16_f32 v11, v58, v59
    global_store_dwordx4 v1, v[8:11], s[8:9] offset:256 nt
    v_pk_mul_f32 v[60:61], v[60:61], v[2:3] op_sel_hi:[1,0]
    v_pk_mul_f32 v[62:63], v[62:63], v[2:3] op_sel_hi:[1,0]
    v_pk_mul_f32 v[64:65], v[64:65], v[2:3] op_sel_hi:[1,0]
    v_pk_mul_f32 v[66:67], v[66:67], v[2:3] op_sel_hi:[1,0]
    v_cvt_pk_bf16_f32 v12, v60, v61
    v_cvt_pk_bf16_f32 v13, v62, v63
    v_cvt_pk_bf16_f32 v14, v64, v65
    v_cvt_pk_bf16_f32 v15, v66, v67
    v_pk_mul_f32 v[68:69], v[68:69], v[2:3] op_sel_hi:[1,0]
    v_pk_mul_f32 v[70:71], v[70:71], v[2:3] op_sel_hi:[1,0]
    v_pk_mul_f32 v[72:73], v[72:73], v[2:3] op_sel_hi:[1,0]
    v_pk_mul_f32 v[74:75], v[74:75], v[2:3] op_sel_hi:[1,0]
    v_cvt_pk_bf16_f32 v16, v68, v69
    v_cvt_pk_bf16_f32 v17, v70, v71
    v_cvt_pk_bf16_f32 v18, v72, v73
    v_cvt_pk_bf16_f32 v19, v74, v75
    v_pk_mul_f32 v[76:77], v[76:77], v[2:3] op_sel_hi:[1,0]
    v_pk_mul_f32 v[78:79], v[78:79], v[2:3] op_sel_hi:[1,0]
    v_pk_mul_f32 v[80:81], v[80:81], v[2:3] op_sel_hi:[1,0]
    v_pk_mul_f32 v[82:83], v[82:83], v[2:3] op_sel_hi:[1,0]
    v_cvt_pk_bf16_f32 v20, v76, v77
    v_cvt_pk_bf16_f32 v21, v78, v79
    v_cvt_pk_bf16_f32 v22, v80, v81
    v_cvt_pk_bf16_f32 v23, v82, v83
    s_cbranch_scc0 L_e2
    s_barrier
L_e2:
    global_store_dwordx4 v1, v[12:15], s[8:9] offset:512 nt
    global_store_dwordx4 v1, v[16:19], s[8:9] offset:768 nt
    global_store_dwordx4 v1, v[20:23], s[8:9] offset:1024 nt
L_done:
    s_endpgm
.section .rodata,"a"
.p2align 6
.amdhsa_kernel standalone__rmsnorm__sampling_kernel
  .amdhsa_next_free_vgpr 88
  .amdhsa_next_free_sgpr 16
  .amdhsa_accum_offset 88
  .amdhsa_group_segment_fixed_size 0
  .amdhsa_kernarg_size 40
  .amdhsa_user_sgpr_count 2
  .amdhsa_user_sgpr_kernarg_segment_ptr 1
  .amdhsa_system_sgpr_workgroup_id_x 1
  .amdhsa_float_denorm_mode_32 3
.end_amdhsa_kernel
```
